```python
import torch

def _softmax(x, axis=-1):
    return torch.softmax(x, dim=axis)

def _gelu(x):
    return torch.nn.functional.gelu(x, approximate='tanh')

def _silu(x):
    return torch.nn.functional.silu(x)

def _sigmoid(x):
    return torch.sigmoid(x)

def _layernorm(x, axis=-1, eps=1e-05):
    m = x.mean(dim=axis, keepdim=True)
    v = x.var(dim=axis, keepdim=True, unbiased=False)
    return (x - m) / torch.sqrt(v + eps)

def _scatter_add(tgt, idx, src, axis=0):
    return tgt.clone().index_add_(axis, idx, src)

def _segment_sum(src, seg, n):
    out = torch.zeros((n,) + src.shape[1:], dtype=src.dtype)
    return out.index_add_(0, seg, src)

def _pad(x, pw):
    flat = tuple((v for pair in reversed(pw) for v in pair))
    return torch.nn.functional.pad(x, flat)
kernel_name = 'standalone__tree_speculative_verify_tree_attention_over_candidate_token_tree__decode'

def setup_inputs():

    _w = lambda a: (lambda t: t.to(torch.bfloat16) if t.is_floating_point() else t)(torch.as_tensor(a))
    B, Hq, Hkv, T, C, D = (1, 32, 16, 1, 32768, 128)
    tree_mask = torch.zeros((B, T, T), dtype=float)
    for b in range(B):
        parent = torch.zeros(T, dtype=torch.int64)
        for i in range(1, T):
            parent[i] = int(torch.randint(0, i, (1,)).item())
        for i in range(T):
            j = i
            tree_mask[b, i, j] = 1.0
            while j > 0:
                j = parent[j]
                tree_mask[b, i, j] = 1.0
    return {'q': _w((lambda *s: torch.randn(*s, dtype=torch.bfloat16) * 0.8)(B, Hq, T, D)), 'k_cache': _w((lambda *s: torch.randn(*s, dtype=torch.bfloat16) * 0.8)(B, Hkv, C, D)), 'v_cache': _w((lambda *s: torch.randn(*s, dtype=torch.bfloat16) * 0.05)(B, Hkv, C, D)), 'k_tree': _w((lambda *s: torch.randn(*s, dtype=torch.bfloat16) * 0.8)(B, Hkv, T, D)), 'v_tree': _w((lambda *s: torch.randn(*s, dtype=torch.bfloat16) * 0.05)(B, Hkv, T, D)), 'tree_mask': _w(tree_mask)}

def reference(q, k_cache, v_cache, k_tree, v_tree, tree_mask):
    B, Hq, T, D = q.shape
    Hkv, C = (k_cache.shape[1], k_cache.shape[2])
    rep = Hq // Hkv
    kc = (lambda x, n, axis: torch.repeat_interleave(x, n, dim=axis))(k_cache, rep, axis=1)
    vc = (lambda x, n, axis: torch.repeat_interleave(x, n, dim=axis))(v_cache, rep, axis=1)
    kt = (lambda x, n, axis: torch.repeat_interleave(x, n, dim=axis))(k_tree, rep, axis=1)
    vt = (lambda x, n, axis: torch.repeat_interleave(x, n, dim=axis))(v_tree, rep, axis=1)
    k = torch.concatenate([kc, kt], axis=2)
    v = torch.concatenate([vc, vt], axis=2)
    scale = D ** (-0.5)
    scores = torch.einsum('bhqd,bhkd->bhqk', q, k) * scale
    ctx_mask = torch.ones((B, 1, T, C), dtype=scores.dtype)
    tm = tree_mask[:, None, :, :].clone()
    full_mask = torch.concatenate([ctx_mask, tm], axis=-1)
    scores = scores + (1.0 - full_mask) * -1000000000.0
    p = _softmax(scores, axis=-1)
    return torch.einsum('bhqk,bhkd->bhqd', p, v)
```

```asm
; @launch grid=(256,1,1) block=(320,1,1) lds=83456
.amdgcn_target "amdgcn-amd-amdhsa--gfx950"
.text
.globl standalone__tree_speculative_verify_tree_attention_over_candidate_token_tree__decode_kernel
.p2align 8
.type standalone__tree_speculative_verify_tree_attention_over_candidate_token_tree__decode_kernel,@function
standalone__tree_speculative_verify_tree_attention_over_candidate_token_tree__decode_kernel:
    s_load_dwordx16 s[4:19], s[0:1], 0
    s_cmp_ge_u32 s2, 256
    s_cbranch_scc1 L_end
    v_lshrrev_b32 v1, 6, v0
    v_and_b32 v0, 63, v0
    s_lshr_b32 s3, s2, 3
    v_readfirstlane_b32 s32, v1
    s_and_b32 s41, s2, 1
    s_lshl1_add_u32 s3, s3, s41
    s_bfe_u32 s34, s2, 0x20001
    v_lshrrev_b32 v1, 4, v0
    v_and_b32 v2, 15, v0
    s_cmp_eq_u32 s32, 4
    s_cbranch_scc1 L_helper
    v_lshlrev_b32 v3, 2, v1
    v_xor_b32 v3, v3, v2
    v_lshlrev_b32 v3, 4, v3
    v_lshl_add_u32 v12, v1, 8, v3
    v_xor_b32 v13, 16, v12
    v_xor_b32 v14, 32, v12
    s_lshl2_add_u32 s35, s34, s32
    s_lshl_b32 s35, s35, 12
    s_lshl_b32 s36, s32, 14
    s_lshl_b32 s41, s3, 21
    s_mov_b32 s26, 2097152
    s_mov_b32 s27, 0x20000
    s_mov_b32 m0, s36
    s_waitcnt lgkmcnt(0)
    s_add_u32 s24, s6, s41
    s_addc_u32 s25, s7, 0
    buffer_load_dwordx4 v12, s[24:27], s35 offen offset:0 nt lds
    buffer_load_dwordx4 v13, s[24:27], s35 offen offset:1024 nt lds
    buffer_load_dwordx4 v14, s[24:27], s35 offen offset:2048 nt lds
    s_load_dwordx2 s[20:21], s[0:1], 64
    v_xor_b32 v15, 48, v12
    s_mov_b32 s75, s35
    s_lshr_b32 s33, s3, 2
    s_lshl2_add_u32 s3, s3, s34
    s_and_b32 s34, s3, 15
    v_and_b32 v3, 1, v0
    v_lshlrev_b32 v4, 4, v1
    v_lshl_add_u32 v7, v3, 8, v4
    s_lshl_b32 s42, s33, 9
    s_add_u32 s4, s4, s42
    s_addc_u32 s5, s5, 0
    global_load_dwordx4 v[28:31], v7, s[4:5] offset:0
    global_load_dwordx4 v[32:35], v7, s[4:5] offset:64
    global_load_dwordx4 v[36:39], v7, s[4:5] offset:128
    global_load_dwordx4 v[40:43], v7, s[4:5] offset:192
    s_or_b32 s43, s32, s34
    s_cbranch_scc1 L_notree0
    s_lshl_b32 s42, s33, 8
    s_add_u32 s10, s10, s42
    s_addc_u32 s11, s11, 0
    s_add_u32 s12, s12, s42
    s_addc_u32 s13, s13, 0
    v_mov_b32 v27, 0
    global_load_ushort v27, v27, s[14:15]
    global_load_dwordx4 v[60:63], v4, s[10:11] offset:0
    global_load_dwordx4 v[64:67], v4, s[10:11] offset:64
    global_load_dwordx4 v[68:71], v4, s[10:11] offset:128
    global_load_dwordx4 v[72:75], v4, s[10:11] offset:192
    v_lshlrev_b32 v3, 4, v2
    global_load_dwordx4 v[108:111], v3, s[12:13]
L_notree0:
    buffer_load_dwordx4 v15, s[24:27], s35 offen offset:3072 nt lds
    s_add_u32 m0, s36, 4096
    s_add_u32 s35, s35, 65536
    buffer_load_dwordx4 v12, s[24:27], s35 offen offset:0 nt lds
    buffer_load_dwordx4 v13, s[24:27], s35 offen offset:1024 nt lds
    buffer_load_dwordx4 v14, s[24:27], s35 offen offset:2048 nt lds
    s_add_u32 s28, s8, s41
    s_addc_u32 s29, s9, 0
    s_mov_b32 s30, 2097152
    s_mov_b32 s31, 0x20000
    v_lshl_add_u32 v5, v0, 4, s75
    v_mov_b32 v176, 82432
    v_lshl_add_u32 v3, v0, 4, v176
    v_mov_b32 v20, 0
    v_mov_b32 v21, 0
    v_mov_b32 v22, 0
    v_mov_b32 v23, 0
    ds_write_b128 v3, v[20:23]
    s_lshl_b32 s41, s32, 7
    s_add_u32 s41, s41, 82684
    v_mov_b32 v8, s41
    s_mov_b32 s58, 63
    s_mov_b32 s59, 0
    s_mov_b32 s74, 0
    v_and_b32 v3, 3, v2
    v_lshlrev_b32 v3, 10, v3
    v_lshrrev_b32 v4, 2, v2
    v_lshl_add_u32 v3, v4, 8, v3
    v_xor_b32 v4, v1, v2
    v_lshl_add_u32 v3, v4, 4, v3
    v_add_u32 v16, s36, v3
    v_xor_b32 v17, 64, v16
    v_xor_b32 v18, 0x80, v16
    v_xor_b32 v19, 0xc0, v16
    v_and_b32 v3, 1, v0
    v_lshl_add_u32 v3, v1, 1, v3
    s_mul_i32 s41, s32, 4224
    s_add_u32 s41, s41, 65536
    v_lshl_add_u32 v6, v3, 4, s41
    s_add_u32 s41, s41, 128
    v_lshl_add_u32 v7, v3, 3, s41
    s_mov_b32 s38, 0x3e0293ee
    s_mov_b32 s39, 0x05040100
    s_mov_b32 s40, 0x07060302
    s_mov_b32 s44, 0x00030003
    s_mov_b32 s45, 0x00030003
    s_mov_b32 s37, 7
    s_waitcnt lgkmcnt(0)
    s_barrier
L_kloop:
    s_waitcnt vmcnt(6)
    s_bitcmp1_b32 s58, 0
    s_cbranch_scc0 L_w1
    s_waitcnt vmcnt(5)
    s_bitcmp1_b32 s58, 4
    s_cbranch_scc0 L_w1
    s_waitcnt vmcnt(4)
L_w1:
    buffer_load_dwordx4 v15, s[24:27], s35 offen offset:3072 nt lds
    s_waitcnt lgkmcnt(0)
    v_mfma_f32_16x16x32_bf16 v[20:23], v[44:47], v[28:31], 0
    v_mfma_f32_16x16x32_bf16 v[20:23], v[48:51], v[32:35], v[20:23]
    v_mfma_f32_16x16x32_bf16 v[20:23], v[52:55], v[36:39], v[20:23]
    v_mfma_f32_16x16x32_bf16 v[20:23], v[56:59], v[40:43], v[20:23]
    s_waitcnt vmcnt(6)
    s_bitcmp1_b32 s58, 1
    s_cbranch_scc0 L_w2
    s_waitcnt vmcnt(5)
    s_bitcmp1_b32 s58, 5
    s_cbranch_scc0 L_w2
    s_waitcnt vmcnt(4)
L_w2:
    s_add_u32 m0, s36, 8192
    s_add_u32 s35, s35, 65536
    buffer_load_dwordx4 v12, s[24:27], s35 offen offset:0 nt lds
    s_waitcnt vmcnt(6)
    s_bitcmp1_b32 s58, 2
    s_cbranch_scc0 L_w3
    s_waitcnt vmcnt(5)
    s_bitcmp1_b32 s58, 6
    s_cbranch_scc0 L_w3
    s_waitcnt vmcnt(4)
L_w3:
    buffer_load_dwordx4 v13, s[24:27], s35 offen offset:1024 nt lds
    s_waitcnt vmcnt(6)
    s_bitcmp1_b32 s58, 3
    s_cbranch_scc0 L_w4
    s_waitcnt vmcnt(5)
    s_bitcmp1_b32 s58, 7
    s_cbranch_scc0 L_w4
    s_waitcnt vmcnt(4)
L_w4:
    buffer_load_dwordx4 v14, s[24:27], s35 offen offset:2048 nt lds
    s_mov_b64 exec, s[44:45]
    ds_write_b128 v6, v[20:23] offset:0
    s_mov_b64 exec, -1
    ds_read_b128 v[44:47], v16 offset:0
    ds_read_b128 v[48:51], v17 offset:0
    ds_read_b128 v[52:55], v18 offset:0
    ds_read_b128 v[56:59], v19 offset:0
    s_waitcnt vmcnt(6)
    s_bitcmp1_b32 s58, 0
    s_cbranch_scc0 L_w5
    s_waitcnt vmcnt(5)
    s_bitcmp1_b32 s58, 4
    s_cbranch_scc0 L_w5
    s_waitcnt vmcnt(4)
L_w5:
    buffer_load_dwordx4 v15, s[24:27], s35 offen offset:3072 nt lds
    s_waitcnt lgkmcnt(0)
    v_mfma_f32_16x16x32_bf16 v[20:23], v[44:47], v[28:31], 0
    v_mfma_f32_16x16x32_bf16 v[20:23], v[48:51], v[32:35], v[20:23]
    v_mfma_f32_16x16x32_bf16 v[20:23], v[52:55], v[36:39], v[20:23]
    v_mfma_f32_16x16x32_bf16 v[20:23], v[56:59], v[40:43], v[20:23]
    s_waitcnt vmcnt(6)
    s_bitcmp1_b32 s58, 1
    s_cbranch_scc0 L_w6
    s_waitcnt vmcnt(5)
    s_bitcmp1_b32 s58, 5
    s_cbranch_scc0 L_w6
    s_waitcnt vmcnt(4)
L_w6:
    s_add_u32 m0, s36, 12288
    s_add_u32 s35, s35, 65536
    buffer_load_dwordx4 v12, s[24:27], s35 offen offset:0 nt lds
    s_waitcnt vmcnt(6)
    s_bitcmp1_b32 s58, 2
    s_cbranch_scc0 L_w7
    s_waitcnt vmcnt(5)
    s_bitcmp1_b32 s58, 6
    s_cbranch_scc0 L_w7
    s_waitcnt vmcnt(4)
L_w7:
    buffer_load_dwordx4 v13, s[24:27], s35 offen offset:1024 nt lds
    s_waitcnt vmcnt(6)
    s_bitcmp1_b32 s58, 3
    s_cbranch_scc0 L_w8
    s_waitcnt vmcnt(5)
    s_bitcmp1_b32 s58, 7
    s_cbranch_scc0 L_w8
    s_waitcnt vmcnt(4)
L_w8:
    buffer_load_dwordx4 v14, s[24:27], s35 offen offset:2048 nt lds
    s_mov_b64 exec, s[44:45]
    ds_write_b128 v6, v[20:23] offset:128
    s_mov_b64 exec, -1
    ds_read_b128 v[44:47], v16 offset:4096
    ds_read_b128 v[48:51], v17 offset:4096
    ds_read_b128 v[52:55], v18 offset:4096
    ds_read_b128 v[56:59], v19 offset:4096
    s_waitcnt vmcnt(6)
    s_bitcmp1_b32 s58, 0
    s_cbranch_scc0 L_w9
    s_waitcnt vmcnt(5)
    s_bitcmp1_b32 s58, 4
    s_cbranch_scc0 L_w9
    s_waitcnt vmcnt(4)
L_w9:
    buffer_load_dwordx4 v15, s[24:27], s35 offen offset:3072 nt lds
    s_waitcnt lgkmcnt(0)
    v_mfma_f32_16x16x32_bf16 v[20:23], v[44:47], v[28:31], 0
    v_mfma_f32_16x16x32_bf16 v[20:23], v[48:51], v[32:35], v[20:23]
    v_mfma_f32_16x16x32_bf16 v[20:23], v[52:55], v[36:39], v[20:23]
    v_mfma_f32_16x16x32_bf16 v[20:23], v[56:59], v[40:43], v[20:23]
    s_waitcnt vmcnt(6)
    s_bitcmp1_b32 s58, 1
    s_cbranch_scc0 L_w10
    s_waitcnt vmcnt(5)
    s_bitcmp1_b32 s58, 5
    s_cbranch_scc0 L_w10
    s_waitcnt vmcnt(4)
L_w10:
    s_add_u32 m0, s36, 0
    s_add_u32 s35, s35, 65536
    buffer_load_dwordx4 v12, s[24:27], s35 offen offset:0 nt lds
    s_waitcnt vmcnt(6)
    s_bitcmp1_b32 s58, 2
    s_cbranch_scc0 L_w11
    s_waitcnt vmcnt(5)
    s_bitcmp1_b32 s58, 6
    s_cbranch_scc0 L_w11
    s_waitcnt vmcnt(4)
L_w11:
    buffer_load_dwordx4 v13, s[24:27], s35 offen offset:1024 nt lds
    s_waitcnt vmcnt(6)
    s_bitcmp1_b32 s58, 3
    s_cbranch_scc0 L_w12
    s_waitcnt vmcnt(5)
    s_bitcmp1_b32 s58, 7
    s_cbranch_scc0 L_w12
    s_waitcnt vmcnt(4)
L_w12:
    buffer_load_dwordx4 v14, s[24:27], s35 offen offset:2048 nt lds
    s_mov_b64 exec, s[44:45]
    ds_write_b128 v6, v[20:23] offset:256
    s_mov_b64 exec, -1
    ds_read_b128 v[44:47], v16 offset:8192
    ds_read_b128 v[48:51], v17 offset:8192
    ds_read_b128 v[52:55], v18 offset:8192
    ds_read_b128 v[56:59], v19 offset:8192
    ds_read_b32 v1, v176
    v_add_u32 v176, 4, v176
    s_waitcnt lgkmcnt(0)
    v_readfirstlane_b32 s72, v1
    s_sub_u32 s72, s72, s74
    s_add_u32 s73, s72, 512
    s_cmp_lt_u32 s73, 1024
    s_cselect_b32 s72, s72, 0
    s_add_i32 s72, s72, 8
    s_ashr_i32 s72, s72, 4
    s_add_i32 s72, s72, 6
    s_max_i32 s72, s72, 0
    s_min_i32 s72, s72, 8
    s_bfm_b32 s58, s72, 0
    s_waitcnt vmcnt(6)
    s_bitcmp1_b32 s58, 0
    s_cbranch_scc0 L_w13
    s_waitcnt vmcnt(5)
    s_bitcmp1_b32 s58, 4
    s_cbranch_scc0 L_w13
    s_waitcnt vmcnt(4)
L_w13:
    buffer_load_dwordx4 v15, s[24:27], s35 offen offset:3072 nt lds
    s_waitcnt lgkmcnt(0)
    v_mfma_f32_16x16x32_bf16 v[20:23], v[44:47], v[28:31], 0
    v_mfma_f32_16x16x32_bf16 v[20:23], v[48:51], v[32:35], v[20:23]
    v_mfma_f32_16x16x32_bf16 v[20:23], v[52:55], v[36:39], v[20:23]
    v_mfma_f32_16x16x32_bf16 v[20:23], v[56:59], v[40:43], v[20:23]
    s_waitcnt vmcnt(6)
    s_bitcmp1_b32 s58, 1
    s_cbranch_scc0 L_w14
    s_waitcnt vmcnt(5)
    s_bitcmp1_b32 s58, 5
    s_cbranch_scc0 L_w14
    s_waitcnt vmcnt(4)
L_w14:
    s_add_u32 m0, s36, 4096
    s_add_u32 s35, s35, 65536
    buffer_load_dwordx4 v12, s[24:27], s35 offen offset:0 nt lds
    s_waitcnt vmcnt(6)
    s_bitcmp1_b32 s58, 2
    s_cbranch_scc0 L_w15
    s_waitcnt vmcnt(5)
    s_bitcmp1_b32 s58, 6
    s_cbranch_scc0 L_w15
    s_waitcnt vmcnt(4)
L_w15:
    buffer_load_dwordx4 v13, s[24:27], s35 offen offset:1024 nt lds
    s_waitcnt vmcnt(6)
    s_bitcmp1_b32 s58, 3
    s_cbranch_scc0 L_w16
    s_waitcnt vmcnt(5)
    s_bitcmp1_b32 s58, 7
    s_cbranch_scc0 L_w16
    s_waitcnt vmcnt(4)
L_w16:
    buffer_load_dwordx4 v14, s[24:27], s35 offen offset:2048 nt lds
    s_mov_b64 exec, s[44:45]
    ds_write_b128 v6, v[20:23] offset:384
    s_mov_b64 exec, -1
    ds_read_b128 v[44:47], v16 offset:12288
    ds_read_b128 v[48:51], v17 offset:12288
    ds_read_b128 v[52:55], v18 offset:12288
    ds_read_b128 v[56:59], v19 offset:12288
    s_memrealtime s[70:71]
    s_mov_b32 s74, s59
    v_add_u32 v8, 4, v8
    s_waitcnt lgkmcnt(0)
    s_or_b32 s59, s70, 1
    v_mov_b32 v1, s59
    s_mov_b64 exec, 1
    ds_write_b32 v8, v1
    s_mov_b64 exec, -1
    v_add_u32 v6, 0x200, v6
    s_sub_u32 s37, s37, 1
    s_cmp_lg_u32 s37, 0
    s_cbranch_scc1 L_kloop
    s_waitcnt vmcnt(6)
    s_bitcmp1_b32 s58, 0
    s_cbranch_scc0 L_w17
    s_waitcnt vmcnt(5)
    s_bitcmp1_b32 s58, 4
    s_cbranch_scc0 L_w17
    s_waitcnt vmcnt(4)
L_w17:
    buffer_load_dwordx4 v15, s[24:27], s35 offen offset:3072 nt lds
    s_waitcnt lgkmcnt(0)
    v_mfma_f32_16x16x32_bf16 v[20:23], v[44:47], v[28:31], 0
    v_mfma_f32_16x16x32_bf16 v[20:23], v[48:51], v[32:35], v[20:23]
    v_mfma_f32_16x16x32_bf16 v[20:23], v[52:55], v[36:39], v[20:23]
    v_mfma_f32_16x16x32_bf16 v[20:23], v[56:59], v[40:43], v[20:23]
    s_waitcnt vmcnt(6)
    s_bitcmp1_b32 s58, 1
    s_cbranch_scc0 L_w18
    s_waitcnt vmcnt(5)
    s_bitcmp1_b32 s58, 5
    s_cbranch_scc0 L_w18
    s_waitcnt vmcnt(4)
L_w18:
    s_add_u32 m0, s36, 8192
    s_add_u32 s35, s35, 65536
    buffer_load_dwordx4 v12, s[24:27], s35 offen offset:0 nt lds
    s_waitcnt vmcnt(6)
    s_bitcmp1_b32 s58, 2
    s_cbranch_scc0 L_w19
    s_waitcnt vmcnt(5)
    s_bitcmp1_b32 s58, 6
    s_cbranch_scc0 L_w19
    s_waitcnt vmcnt(4)
L_w19:
    buffer_load_dwordx4 v13, s[24:27], s35 offen offset:1024 nt lds
    s_waitcnt vmcnt(6)
    s_bitcmp1_b32 s58, 3
    s_cbranch_scc0 L_w20
    s_waitcnt vmcnt(5)
    s_bitcmp1_b32 s58, 7
    s_cbranch_scc0 L_w20
    s_waitcnt vmcnt(4)
L_w20:
    buffer_load_dwordx4 v14, s[24:27], s35 offen offset:2048 nt lds
    s_mov_b64 exec, s[44:45]
    ds_write_b128 v6, v[20:23] offset:0
    s_mov_b64 exec, -1
    ds_read_b128 v[44:47], v16 offset:0
    ds_read_b128 v[48:51], v17 offset:0
    ds_read_b128 v[52:55], v18 offset:0
    ds_read_b128 v[56:59], v19 offset:0
    s_waitcnt vmcnt(6)
    s_bitcmp1_b32 s58, 0
    s_cbranch_scc0 L_w21
    s_waitcnt vmcnt(5)
    s_bitcmp1_b32 s58, 4
    s_cbranch_scc0 L_w21
    s_waitcnt vmcnt(4)
L_w21:
    buffer_load_dwordx4 v15, s[24:27], s35 offen offset:3072 nt lds
    s_waitcnt lgkmcnt(0)
    v_mfma_f32_16x16x32_bf16 v[20:23], v[44:47], v[28:31], 0
    v_mfma_f32_16x16x32_bf16 v[20:23], v[48:51], v[32:35], v[20:23]
    v_mfma_f32_16x16x32_bf16 v[20:23], v[52:55], v[36:39], v[20:23]
    v_mfma_f32_16x16x32_bf16 v[20:23], v[56:59], v[40:43], v[20:23]
    s_waitcnt vmcnt(6)
    s_bitcmp1_b32 s58, 1
    s_cbranch_scc0 L_w22
    s_waitcnt vmcnt(5)
    s_bitcmp1_b32 s58, 5
    s_cbranch_scc0 L_w22
    s_waitcnt vmcnt(4)
L_w22:
    s_add_u32 m0, s36, 12288
    s_add_u32 s35, s35, 65536
    buffer_load_dwordx4 v12, s[24:27], s35 offen offset:0 nt lds
    s_waitcnt vmcnt(6)
    s_bitcmp1_b32 s58, 2
    s_cbranch_scc0 L_w23
    s_waitcnt vmcnt(5)
    s_bitcmp1_b32 s58, 6
    s_cbranch_scc0 L_w23
    s_waitcnt vmcnt(4)
L_w23:
    buffer_load_dwordx4 v13, s[24:27], s35 offen offset:1024 nt lds
    s_waitcnt vmcnt(6)
    s_bitcmp1_b32 s58, 3
    s_cbranch_scc0 L_w24
    s_waitcnt vmcnt(5)
    s_bitcmp1_b32 s58, 7
    s_cbranch_scc0 L_w24
    s_waitcnt vmcnt(4)
L_w24:
    buffer_load_dwordx4 v14, s[24:27], s35 offen offset:2048 nt lds
    s_mov_b64 exec, s[44:45]
    ds_write_b128 v6, v[20:23] offset:128
    s_mov_b64 exec, -1
    ds_read_b128 v[44:47], v16 offset:4096
    ds_read_b128 v[48:51], v17 offset:4096
    ds_read_b128 v[52:55], v18 offset:4096
    ds_read_b128 v[56:59], v19 offset:4096
    s_waitcnt vmcnt(6)
    s_bitcmp1_b32 s58, 0
    s_cbranch_scc0 L_w25
    s_waitcnt vmcnt(5)
    s_bitcmp1_b32 s58, 4
    s_cbranch_scc0 L_w25
    s_waitcnt vmcnt(4)
L_w25:
    buffer_load_dwordx4 v15, s[24:27], s35 offen offset:3072 nt lds
    s_waitcnt lgkmcnt(0)
    v_mfma_f32_16x16x32_bf16 v[20:23], v[44:47], v[28:31], 0
    v_mfma_f32_16x16x32_bf16 v[20:23], v[48:51], v[32:35], v[20:23]
    v_mfma_f32_16x16x32_bf16 v[20:23], v[52:55], v[36:39], v[20:23]
    v_mfma_f32_16x16x32_bf16 v[20:23], v[56:59], v[40:43], v[20:23]
    s_waitcnt vmcnt(6)
    s_bitcmp1_b32 s58, 1
    s_cbranch_scc0 L_w26
    s_waitcnt vmcnt(5)
    s_bitcmp1_b32 s58, 5
    s_cbranch_scc0 L_w26
    s_waitcnt vmcnt(4)
L_w26:
    buffer_load_dwordx4 v[112:115], v5, s[28:31], 0 offen offset:0 nt
    s_waitcnt vmcnt(6)
    s_bitcmp1_b32 s58, 2
    s_cbranch_scc0 L_w27
    s_waitcnt vmcnt(5)
    s_bitcmp1_b32 s58, 6
    s_cbranch_scc0 L_w27
    s_waitcnt vmcnt(4)
L_w27:
    buffer_load_dwordx4 v[116:119], v5, s[28:31], 0 offen offset:1024 nt
    s_waitcnt vmcnt(6)
    s_bitcmp1_b32 s58, 3
    s_cbranch_scc0 L_w28
    s_waitcnt vmcnt(5)
    s_bitcmp1_b32 s58, 7
    s_cbranch_scc0 L_w28
    s_waitcnt vmcnt(4)
L_w28:
    buffer_load_dwordx4 v[120:123], v5, s[28:31], 0 offen offset:2048 nt
    s_mov_b64 exec, s[44:45]
    ds_write_b128 v6, v[20:23] offset:256
    s_mov_b64 exec, -1
    ds_read_b128 v[44:47], v16 offset:8192
    ds_read_b128 v[48:51], v17 offset:8192
    ds_read_b128 v[52:55], v18 offset:8192
    ds_read_b128 v[56:59], v19 offset:8192
    ds_read_b32 v1, v176
    v_add_u32 v176, 4, v176
    s_waitcnt lgkmcnt(0)
    v_readfirstlane_b32 s72, v1
    s_sub_u32 s72, s72, s74
    s_add_u32 s73, s72, 512
    s_cmp_lt_u32 s73, 1024
    s_cselect_b32 s72, s72, 0
    s_add_i32 s72, s72, 8
    s_ashr_i32 s72, s72, 4
    s_add_i32 s72, s72, 6
    s_max_i32 s72, s72, 0
    s_min_i32 s72, s72, 8
    s_bfm_b32 s58, s72, 0
    s_waitcnt vmcnt(6)
    s_bitcmp1_b32 s58, 0
    s_cbranch_scc0 L_w29
    s_waitcnt vmcnt(5)
    s_bitcmp1_b32 s58, 4
    s_cbranch_scc0 L_w29
    s_waitcnt vmcnt(4)
L_w29:
    buffer_load_dwordx4 v[124:127], v5, s[28:31], 0 offen offset:3072 nt
    s_waitcnt lgkmcnt(0)
    v_mfma_f32_16x16x32_bf16 v[20:23], v[44:47], v[28:31], 0
    v_mfma_f32_16x16x32_bf16 v[20:23], v[48:51], v[32:35], v[20:23]
    v_mfma_f32_16x16x32_bf16 v[20:23], v[52:55], v[36:39], v[20:23]
    v_mfma_f32_16x16x32_bf16 v[20:23], v[56:59], v[40:43], v[20:23]
    s_waitcnt vmcnt(6)
    s_bitcmp1_b32 s58, 1
    s_cbranch_scc0 L_w30
    s_waitcnt vmcnt(5)
    s_bitcmp1_b32 s58, 5
    s_cbranch_scc0 L_w30
    s_waitcnt vmcnt(4)
L_w30:
    v_add_u32 v5, 65536, v5
    buffer_load_dwordx4 v[128:131], v5, s[28:31], 0 offen offset:0 nt
    s_waitcnt vmcnt(6)
    s_bitcmp1_b32 s58, 2
    s_cbranch_scc0 L_w31
    s_waitcnt vmcnt(5)
    s_bitcmp1_b32 s58, 6
    s_cbranch_scc0 L_w31
    s_waitcnt vmcnt(4)
L_w31:
    buffer_load_dwordx4 v[132:135], v5, s[28:31], 0 offen offset:1024 nt
    s_waitcnt vmcnt(6)
    s_bitcmp1_b32 s58, 3
    s_cbranch_scc0 L_w32
    s_waitcnt vmcnt(5)
    s_bitcmp1_b32 s58, 7
    s_cbranch_scc0 L_w32
    s_waitcnt vmcnt(4)
L_w32:
    buffer_load_dwordx4 v[136:139], v5, s[28:31], 0 offen offset:2048 nt
    s_mov_b64 exec, s[44:45]
    ds_write_b128 v6, v[20:23] offset:384
    s_mov_b64 exec, -1
    ds_read_b128 v[44:47], v16 offset:12288
    ds_read_b128 v[48:51], v17 offset:12288
    ds_read_b128 v[52:55], v18 offset:12288
    ds_read_b128 v[56:59], v19 offset:12288
    s_waitcnt lgkmcnt(0)
    v_mfma_f32_16x16x32_bf16 v[20:23], v[44:47], v[28:31], 0
    v_mfma_f32_16x16x32_bf16 v[20:23], v[48:51], v[32:35], v[20:23]
    v_mfma_f32_16x16x32_bf16 v[20:23], v[52:55], v[36:39], v[20:23]
    v_mfma_f32_16x16x32_bf16 v[20:23], v[56:59], v[40:43], v[20:23]
    s_memrealtime s[70:71]
    s_mov_b32 s74, s59
    v_add_u32 v8, 4, v8
    s_waitcnt lgkmcnt(0)
    s_or_b32 s59, s70, 1
    v_mov_b32 v1, s59
    s_mov_b64 exec, 1
    ds_write_b32 v8, v1
    s_mov_b64 exec, -1
    v_mov_b32 v26, 0xff800000
    s_mul_i32 s41, s32, 4224
    s_add_u32 s41, s41, 65664
    v_lshl_add_u32 v3, v0, 4, s41
    v_lshl_add_u32 v4, v0, 3, s41
    s_mov_b64 exec, s[44:45]
    ds_write_b128 v6, v[20:23] offset:512
    s_mov_b64 exec, -1
    ds_read_b128 v[44:47], v3 offset:0
    ds_read_b128 v[48:51], v3 offset:1024
    ds_read_b128 v[52:55], v3 offset:2048
    ds_read_b128 v[56:59], v3 offset:3072
    s_cmp_lg_u32 s43, 0
    s_cbranch_scc1 L_notree1
    v_mfma_f32_16x16x32_bf16 v[20:23], v[60:63], v[28:31], 0
    v_mfma_f32_16x16x32_bf16 v[20:23], v[64:67], v[32:35], v[20:23]
    v_mfma_f32_16x16x32_bf16 v[20:23], v[68:71], v[36:39], v[20:23]
    v_mfma_f32_16x16x32_bf16 v[20:23], v[72:75], v[40:43], v[20:23]
    v_lshlrev_b32 v27, 16, v27
    v_sub_f32 v27, 1.0, v27
    v_mul_f32 v27, 0xceabfb8f, v27
    s_nop 4
    v_fma_f32 v26, v20, s38, v27
L_notree1:
    s_waitcnt lgkmcnt(0)
    v_max3_f32 v10, v44, v45, v46
    v_max3_f32 v1, v47, v48, v49
    v_max3_f32 v10, v10, v50, v51
    v_max3_f32 v1, v1, v52, v53
    v_max3_f32 v10, v10, v54, v55
    v_max3_f32 v1, v1, v56, v57
    v_max3_f32 v10, v10, v58, v59
    v_max_f32 v10, v10, v1
    v_mul_f32 v10, s38, v10
    v_max_f32 v10, v10, v26
    s_waitcnt vmcnt(6)
    s_bitcmp1_b32 s58, 0
    s_cbranch_scc0 L_w33
    s_waitcnt vmcnt(5)
    s_bitcmp1_b32 s58, 4
    s_cbranch_scc0 L_w33
    s_waitcnt vmcnt(4)
L_w33:
    buffer_load_dwordx4 v[140:143], v5, s[28:31], 0 offen offset:3072 nt
    s_nop 1
    v_max_f32_dpp v10, v10, v10 row_ror:2 row_mask:0xf bank_mask:0xf
    s_nop 1
    v_max_f32_dpp v10, v10, v10 row_ror:4 row_mask:0xf bank_mask:0xf
    s_nop 1
    v_max_f32_dpp v10, v10, v10 row_ror:8 row_mask:0xf bank_mask:0xf
    v_mov_b32 v1, v10
    s_nop 1
    v_permlane16_swap_b32 v10, v1
    v_max_f32 v10, v10, v1
    v_mov_b32 v1, v10
    s_nop 1
    v_permlane32_swap_b32 v10, v1
    v_max_f32 v10, v10, v1
    v_fma_f32 v44, v44, s38, -v10
    v_fma_f32 v45, v45, s38, -v10
    v_fma_f32 v46, v46, s38, -v10
    v_fma_f32 v47, v47, s38, -v10
    v_fma_f32 v48, v48, s38, -v10
    v_fma_f32 v49, v49, s38, -v10
    v_fma_f32 v50, v50, s38, -v10
    v_fma_f32 v51, v51, s38, -v10
    v_fma_f32 v52, v52, s38, -v10
    v_fma_f32 v53, v53, s38, -v10
    v_fma_f32 v54, v54, s38, -v10
    v_fma_f32 v55, v55, s38, -v10
    v_fma_f32 v56, v56, s38, -v10
    v_fma_f32 v57, v57, s38, -v10
    v_fma_f32 v58, v58, s38, -v10
    v_fma_f32 v59, v59, s38, -v10
    v_sub_f32 v26, v26, v10
    s_waitcnt vmcnt(6)
    s_bitcmp1_b32 s58, 1
    s_cbranch_scc0 L_w34
    s_waitcnt vmcnt(5)
    s_bitcmp1_b32 s58, 5
    s_cbranch_scc0 L_w34
    s_waitcnt vmcnt(4)
L_w34:
    v_add_u32 v5, 65536, v5
    buffer_load_dwordx4 v[144:147], v5, s[28:31], 0 offen offset:0 nt
    v_exp_f32 v44, v44
    v_exp_f32 v45, v45
    v_exp_f32 v46, v46
    v_exp_f32 v47, v47
    v_exp_f32 v48, v48
    v_exp_f32 v49, v49
    v_exp_f32 v50, v50
    v_exp_f32 v51, v51
    v_exp_f32 v52, v52
    v_exp_f32 v53, v53
    v_exp_f32 v54, v54
    v_exp_f32 v55, v55
    v_exp_f32 v56, v56
    v_exp_f32 v57, v57
    v_exp_f32 v58, v58
    v_exp_f32 v59, v59
    v_exp_f32 v26, v26
    v_cvt_pk_bf16_f32 v28, v44, v45
    v_cvt_pk_bf16_f32 v29, v46, v47
    ds_write_b64 v4, v[28:29] offset:0
    v_cvt_pk_bf16_f32 v30, v48, v49
    v_cvt_pk_bf16_f32 v31, v50, v51
    ds_write_b64 v4, v[30:31] offset:512
    v_cvt_pk_bf16_f32 v32, v52, v53
    v_cvt_pk_bf16_f32 v33, v54, v55
    ds_write_b64 v4, v[32:33] offset:1024
    v_cvt_pk_bf16_f32 v34, v56, v57
    v_cvt_pk_bf16_f32 v35, v58, v59
    ds_write_b64 v4, v[34:35] offset:1536
    ds_read_b64 v[24:25], v7
    s_waitcnt vmcnt(6)
    s_bitcmp1_b32 s58, 2
    s_cbranch_scc0 L_w35
    s_waitcnt vmcnt(5)
    s_bitcmp1_b32 s58, 6
    s_cbranch_scc0 L_w35
    s_waitcnt vmcnt(4)
L_w35:
    buffer_load_dwordx4 v[148:151], v5, s[28:31], 0 offen offset:1024 nt
    v_add_f32 v44, v44, v45
    v_add_f32 v46, v46, v47
    v_add_f32 v48, v48, v49
    v_add_f32 v50, v50, v51
    v_add_f32 v52, v52, v53
    v_add_f32 v54, v54, v55
    v_add_f32 v56, v56, v57
    v_add_f32 v58, v58, v59
    v_add_f32 v44, v44, v46
    v_add_f32 v48, v48, v50
    v_add_f32 v52, v52, v54
    v_add_f32 v56, v56, v58
    v_add_f32 v44, v44, v48
    v_add_f32 v52, v52, v56
    v_add_f32 v44, v44, v52
    v_mov_b32 v11, v44
    s_nop 1
    v_add_f32_dpp v11, v11, v11 row_ror:2 row_mask:0xf bank_mask:0xf
    s_nop 1
    v_add_f32_dpp v11, v11, v11 row_ror:4 row_mask:0xf bank_mask:0xf
    s_nop 1
    v_add_f32_dpp v11, v11, v11 row_ror:8 row_mask:0xf bank_mask:0xf
    v_mov_b32 v1, v11
    s_nop 1
    v_permlane16_swap_b32 v11, v1
    v_add_f32 v11, v11, v1
    v_mov_b32 v1, v11
    s_nop 1
    v_permlane32_swap_b32 v11, v1
    v_add_f32 v11, v11, v1
    v_add_f32 v11, v11, v26
    v_mov_b32 v76, 0
    v_mov_b32 v77, 0
    v_mov_b32 v78, 0
    v_mov_b32 v79, 0
    v_mov_b32 v80, 0
    v_mov_b32 v81, 0
    v_mov_b32 v82, 0
    v_mov_b32 v83, 0
    v_mov_b32 v84, 0
    v_mov_b32 v85, 0
    v_mov_b32 v86, 0
    v_mov_b32 v87, 0
    v_mov_b32 v88, 0
    v_mov_b32 v89, 0
    v_mov_b32 v90, 0
    v_mov_b32 v91, 0
    v_mov_b32 v92, 0
    v_mov_b32 v93, 0
    v_mov_b32 v94, 0
    v_mov_b32 v95, 0
    v_mov_b32 v96, 0
    v_mov_b32 v97, 0
    v_mov_b32 v98, 0
    v_mov_b32 v99, 0
    v_mov_b32 v100, 0
    v_mov_b32 v101, 0
    v_mov_b32 v102, 0
    v_mov_b32 v103, 0
    v_mov_b32 v104, 0
    v_mov_b32 v105, 0
    v_mov_b32 v106, 0
    v_mov_b32 v107, 0
    s_cmp_lg_u32 s43, 0
    s_cbranch_scc1 L_notree2
    v_readlane_b32 s41, v26, 0
    v_readlane_b32 s42, v26, 1
    v_lshlrev_b32 v1, 16, v108
    v_mul_f32 v76, s41, v1
    v_mul_f32 v77, s42, v1
    v_and_b32 v1, 0xffff0000, v108
    v_mul_f32 v80, s41, v1
    v_mul_f32 v81, s42, v1
    v_lshlrev_b32 v1, 16, v109
    v_mul_f32 v84, s41, v1
    v_mul_f32 v85, s42, v1
    v_and_b32 v1, 0xffff0000, v109
    v_mul_f32 v88, s41, v1
    v_mul_f32 v89, s42, v1
    v_lshlrev_b32 v1, 16, v110
    v_mul_f32 v92, s41, v1
    v_mul_f32 v93, s42, v1
    v_and_b32 v1, 0xffff0000, v110
    v_mul_f32 v96, s41, v1
    v_mul_f32 v97, s42, v1
    v_lshlrev_b32 v1, 16, v111
    v_mul_f32 v100, s41, v1
    v_mul_f32 v101, s42, v1
    v_and_b32 v1, 0xffff0000, v111
    v_mul_f32 v104, s41, v1
    v_mul_f32 v105, s42, v1
L_notree2:
    s_mov_b32 s37, 7
    v_perm_b32 v60, v116, v112, s39
    v_perm_b32 v62, v116, v112, s40
    v_perm_b32 v64, v117, v113, s39
    v_perm_b32 v66, v117, v113, s40
    v_perm_b32 v68, v118, v114, s39
    v_perm_b32 v70, v118, v114, s40
    v_perm_b32 v72, v119, v115, s39
    v_perm_b32 v74, v119, v115, s40
    s_waitcnt vmcnt(6)
    s_bitcmp1_b32 s58, 3
    s_cbranch_scc0 L_w36
    s_waitcnt vmcnt(5)
    s_bitcmp1_b32 s58, 7
    s_cbranch_scc0 L_w36
    s_waitcnt vmcnt(4)
L_w36:
    buffer_load_dwordx4 v[152:155], v5, s[28:31], 0 offen offset:2048 nt
    v_perm_b32 v61, v124, v120, s39
    v_perm_b32 v63, v124, v120, s40
    v_perm_b32 v65, v125, v121, s39
    v_perm_b32 v67, v125, v121, s40
    v_perm_b32 v69, v126, v122, s39
    v_perm_b32 v71, v126, v122, s40
    v_perm_b32 v73, v127, v123, s39
    v_perm_b32 v75, v127, v123, s40
    s_waitcnt lgkmcnt(0)
    v_mfma_f32_16x16x16_bf16 v[76:79], v[24:25], v[60:61], v[76:79]
    v_mfma_f32_16x16x16_bf16 v[80:83], v[24:25], v[62:63], v[80:83]
    v_mfma_f32_16x16x16_bf16 v[84:87], v[24:25], v[64:65], v[84:87]
    v_mfma_f32_16x16x16_bf16 v[88:91], v[24:25], v[66:67], v[88:91]
    v_mfma_f32_16x16x16_bf16 v[92:95], v[24:25], v[68:69], v[92:95]
    v_mfma_f32_16x16x16_bf16 v[96:99], v[24:25], v[70:71], v[96:99]
    v_mfma_f32_16x16x16_bf16 v[100:103], v[24:25], v[72:73], v[100:103]
    v_mfma_f32_16x16x16_bf16 v[104:107], v[24:25], v[74:75], v[104:107]
    s_branch L_vloop1
L_vloop:
    s_waitcnt vmcnt(6)
    s_bitcmp1_b32 s58, 0
    s_cbranch_scc0 L_w37
    s_waitcnt vmcnt(5)
    s_bitcmp1_b32 s58, 4
    s_cbranch_scc0 L_w37
    s_waitcnt vmcnt(4)
L_w37:
    buffer_load_dwordx4 v[140:143], v5, s[28:31], 0 offen offset:3072 nt
    ds_read_b64 v[24:25], v7 offset:0
    s_waitcnt vmcnt(6)
    s_bitcmp1_b32 s58, 1
    s_cbranch_scc0 L_w38
    s_waitcnt vmcnt(5)
    s_bitcmp1_b32 s58, 5
    s_cbranch_scc0 L_w38
    s_waitcnt vmcnt(4)
L_w38:
    v_add_u32 v5, 65536, v5
    buffer_load_dwordx4 v[144:147], v5, s[28:31], 0 offen offset:0 nt
    v_perm_b32 v60, v116, v112, s39
    v_perm_b32 v62, v116, v112, s40
    v_perm_b32 v64, v117, v113, s39
    v_perm_b32 v66, v117, v113, s40
    v_perm_b32 v68, v118, v114, s39
    v_perm_b32 v70, v118, v114, s40
    v_perm_b32 v72, v119, v115, s39
    v_perm_b32 v74, v119, v115, s40
    s_waitcnt vmcnt(6)
    s_bitcmp1_b32 s58, 2
    s_cbranch_scc0 L_w39
    s_waitcnt vmcnt(5)
    s_bitcmp1_b32 s58, 6
    s_cbranch_scc0 L_w39
    s_waitcnt vmcnt(4)
L_w39:
    buffer_load_dwordx4 v[148:151], v5, s[28:31], 0 offen offset:1024 nt
    s_waitcnt vmcnt(6)
    s_bitcmp1_b32 s58, 3
    s_cbranch_scc0 L_w40
    s_waitcnt vmcnt(5)
    s_bitcmp1_b32 s58, 7
    s_cbranch_scc0 L_w40
    s_waitcnt vmcnt(4)
L_w40:
    buffer_load_dwordx4 v[152:155], v5, s[28:31], 0 offen offset:2048 nt
    v_perm_b32 v61, v124, v120, s39
    v_perm_b32 v63, v124, v120, s40
    v_perm_b32 v65, v125, v121, s39
    v_perm_b32 v67, v125, v121, s40
    v_perm_b32 v69, v126, v122, s39
    v_perm_b32 v71, v126, v122, s40
    v_perm_b32 v73, v127, v123, s39
    v_perm_b32 v75, v127, v123, s40
    s_waitcnt lgkmcnt(0)
    v_mfma_f32_16x16x16_bf16 v[76:79], v[24:25], v[60:61], v[76:79]
    v_mfma_f32_16x16x16_bf16 v[80:83], v[24:25], v[62:63], v[80:83]
    v_mfma_f32_16x16x16_bf16 v[84:87], v[24:25], v[64:65], v[84:87]
    v_mfma_f32_16x16x16_bf16 v[88:91], v[24:25], v[66:67], v[88:91]
    v_mfma_f32_16x16x16_bf16 v[92:95], v[24:25], v[68:69], v[92:95]
    v_mfma_f32_16x16x16_bf16 v[96:99], v[24:25], v[70:71], v[96:99]
    v_mfma_f32_16x16x16_bf16 v[100:103], v[24:25], v[72:73], v[100:103]
    v_mfma_f32_16x16x16_bf16 v[104:107], v[24:25], v[74:75], v[104:107]
L_vloop1:
    s_waitcnt vmcnt(6)
    s_bitcmp1_b32 s58, 0
    s_cbranch_scc0 L_w41
    s_waitcnt vmcnt(5)
    s_bitcmp1_b32 s58, 4
    s_cbranch_scc0 L_w41
    s_waitcnt vmcnt(4)
L_w41:
    buffer_load_dwordx4 v[156:159], v5, s[28:31], 0 offen offset:3072 nt
    ds_read_b64 v[24:25], v7 offset:64
    s_waitcnt vmcnt(6)
    s_bitcmp1_b32 s58, 1
    s_cbranch_scc0 L_w42
    s_waitcnt vmcnt(5)
    s_bitcmp1_b32 s58, 5
    s_cbranch_scc0 L_w42
    s_waitcnt vmcnt(4)
L_w42:
    v_add_u32 v5, 65536, v5
    buffer_load_dwordx4 v[160:163], v5, s[28:31], 0 offen offset:0 nt
    v_perm_b32 v60, v132, v128, s39
    v_perm_b32 v62, v132, v128, s40
    v_perm_b32 v64, v133, v129, s39
    v_perm_b32 v66, v133, v129, s40
    v_perm_b32 v68, v134, v130, s39
    v_perm_b32 v70, v134, v130, s40
    v_perm_b32 v72, v135, v131, s39
    v_perm_b32 v74, v135, v131, s40
    s_waitcnt vmcnt(6)
    s_bitcmp1_b32 s58, 2
    s_cbranch_scc0 L_w43
    s_waitcnt vmcnt(5)
    s_bitcmp1_b32 s58, 6
    s_cbranch_scc0 L_w43
    s_waitcnt vmcnt(4)
L_w43:
    buffer_load_dwordx4 v[164:167], v5, s[28:31], 0 offen offset:1024 nt
    s_waitcnt vmcnt(6)
    s_bitcmp1_b32 s58, 3
    s_cbranch_scc0 L_w44
    s_waitcnt vmcnt(5)
    s_bitcmp1_b32 s58, 7
    s_cbranch_scc0 L_w44
    s_waitcnt vmcnt(4)
L_w44:
    buffer_load_dwordx4 v[168:171], v5, s[28:31], 0 offen offset:2048 nt
    v_perm_b32 v61, v140, v136, s39
    v_perm_b32 v63, v140, v136, s40
    v_perm_b32 v65, v141, v137, s39
    v_perm_b32 v67, v141, v137, s40
    v_perm_b32 v69, v142, v138, s39
    v_perm_b32 v71, v142, v138, s40
    v_perm_b32 v73, v143, v139, s39
    v_perm_b32 v75, v143, v139, s40
    s_waitcnt lgkmcnt(0)
    v_mfma_f32_16x16x16_bf16 v[76:79], v[24:25], v[60:61], v[76:79]
    v_mfma_f32_16x16x16_bf16 v[80:83], v[24:25], v[62:63], v[80:83]
    v_mfma_f32_16x16x16_bf16 v[84:87], v[24:25], v[64:65], v[84:87]
    v_mfma_f32_16x16x16_bf16 v[88:91], v[24:25], v[66:67], v[88:91]
    v_mfma_f32_16x16x16_bf16 v[92:95], v[24:25], v[68:69], v[92:95]
    v_mfma_f32_16x16x16_bf16 v[96:99], v[24:25], v[70:71], v[96:99]
    v_mfma_f32_16x16x16_bf16 v[100:103], v[24:25], v[72:73], v[100:103]
    v_mfma_f32_16x16x16_bf16 v[104:107], v[24:25], v[74:75], v[104:107]
    s_waitcnt vmcnt(6)
    s_bitcmp1_b32 s58, 0
    s_cbranch_scc0 L_w45
    s_waitcnt vmcnt(5)
    s_bitcmp1_b32 s58, 4
    s_cbranch_scc0 L_w45
    s_waitcnt vmcnt(4)
L_w45:
    buffer_load_dwordx4 v[172:175], v5, s[28:31], 0 offen offset:3072 nt
    ds_read_b64 v[24:25], v7 offset:128
    s_waitcnt vmcnt(6)
    s_bitcmp1_b32 s58, 1
    s_cbranch_scc0 L_w46
    s_waitcnt vmcnt(5)
    s_bitcmp1_b32 s58, 5
    s_cbranch_scc0 L_w46
    s_waitcnt vmcnt(4)
L_w46:
    v_add_u32 v5, 65536, v5
    buffer_load_dwordx4 v[112:115], v5, s[28:31], 0 offen offset:0 nt
    v_perm_b32 v60, v148, v144, s39
    v_perm_b32 v62, v148, v144, s40
    v_perm_b32 v64, v149, v145, s39
    v_perm_b32 v66, v149, v145, s40
    v_perm_b32 v68, v150, v146, s39
    v_perm_b32 v70, v150, v146, s40
    v_perm_b32 v72, v151, v147, s39
    v_perm_b32 v74, v151, v147, s40
    s_waitcnt vmcnt(6)
    s_bitcmp1_b32 s58, 2
    s_cbranch_scc0 L_w47
    s_waitcnt vmcnt(5)
    s_bitcmp1_b32 s58, 6
    s_cbranch_scc0 L_w47
    s_waitcnt vmcnt(4)
L_w47:
    buffer_load_dwordx4 v[116:119], v5, s[28:31], 0 offen offset:1024 nt
    s_waitcnt vmcnt(6)
    s_bitcmp1_b32 s58, 3
    s_cbranch_scc0 L_w48
    s_waitcnt vmcnt(5)
    s_bitcmp1_b32 s58, 7
    s_cbranch_scc0 L_w48
    s_waitcnt vmcnt(4)
L_w48:
    buffer_load_dwordx4 v[120:123], v5, s[28:31], 0 offen offset:2048 nt
    v_perm_b32 v61, v156, v152, s39
    v_perm_b32 v63, v156, v152, s40
    v_perm_b32 v65, v157, v153, s39
    v_perm_b32 v67, v157, v153, s40
    v_perm_b32 v69, v158, v154, s39
    v_perm_b32 v71, v158, v154, s40
    v_perm_b32 v73, v159, v155, s39
    v_perm_b32 v75, v159, v155, s40
    s_waitcnt lgkmcnt(0)
    v_mfma_f32_16x16x16_bf16 v[76:79], v[24:25], v[60:61], v[76:79]
    v_mfma_f32_16x16x16_bf16 v[80:83], v[24:25], v[62:63], v[80:83]
    v_mfma_f32_16x16x16_bf16 v[84:87], v[24:25], v[64:65], v[84:87]
    v_mfma_f32_16x16x16_bf16 v[88:91], v[24:25], v[66:67], v[88:91]
    v_mfma_f32_16x16x16_bf16 v[92:95], v[24:25], v[68:69], v[92:95]
    v_mfma_f32_16x16x16_bf16 v[96:99], v[24:25], v[70:71], v[96:99]
    v_mfma_f32_16x16x16_bf16 v[100:103], v[24:25], v[72:73], v[100:103]
    v_mfma_f32_16x16x16_bf16 v[104:107], v[24:25], v[74:75], v[104:107]
    ds_read_b32 v1, v176
    v_add_u32 v176, 4, v176
    s_waitcnt lgkmcnt(0)
    v_readfirstlane_b32 s72, v1
    s_sub_u32 s72, s72, s74
    s_add_u32 s73, s72, 512
    s_cmp_lt_u32 s73, 1024
    s_cselect_b32 s72, s72, 0
    s_add_i32 s72, s72, 8
    s_ashr_i32 s72, s72, 4
    s_add_i32 s72, s72, 6
    s_max_i32 s72, s72, 0
    s_min_i32 s72, s72, 8
    s_bfm_b32 s58, s72, 0
    s_waitcnt vmcnt(6)
    s_bitcmp1_b32 s58, 0
    s_cbranch_scc0 L_w49
    s_waitcnt vmcnt(5)
    s_bitcmp1_b32 s58, 4
    s_cbranch_scc0 L_w49
    s_waitcnt vmcnt(4)
L_w49:
    buffer_load_dwordx4 v[124:127], v5, s[28:31], 0 offen offset:3072 nt
    ds_read_b64 v[24:25], v7 offset:192
    s_waitcnt vmcnt(6)
    s_bitcmp1_b32 s58, 1
    s_cbranch_scc0 L_w50
    s_waitcnt vmcnt(5)
    s_bitcmp1_b32 s58, 5
    s_cbranch_scc0 L_w50
    s_waitcnt vmcnt(4)
L_w50:
    v_add_u32 v5, 65536, v5
    buffer_load_dwordx4 v[128:131], v5, s[28:31], 0 offen offset:0 nt
    v_perm_b32 v60, v164, v160, s39
    v_perm_b32 v62, v164, v160, s40
    v_perm_b32 v64, v165, v161, s39
    v_perm_b32 v66, v165, v161, s40
    v_perm_b32 v68, v166, v162, s39
    v_perm_b32 v70, v166, v162, s40
    v_perm_b32 v72, v167, v163, s39
    v_perm_b32 v74, v167, v163, s40
    s_waitcnt vmcnt(6)
    s_bitcmp1_b32 s58, 2
    s_cbranch_scc0 L_w51
    s_waitcnt vmcnt(5)
    s_bitcmp1_b32 s58, 6
    s_cbranch_scc0 L_w51
    s_waitcnt vmcnt(4)
L_w51:
    buffer_load_dwordx4 v[132:135], v5, s[28:31], 0 offen offset:1024 nt
    s_waitcnt vmcnt(6)
    s_bitcmp1_b32 s58, 3
    s_cbranch_scc0 L_w52
    s_waitcnt vmcnt(5)
    s_bitcmp1_b32 s58, 7
    s_cbranch_scc0 L_w52
    s_waitcnt vmcnt(4)
L_w52:
    buffer_load_dwordx4 v[136:139], v5, s[28:31], 0 offen offset:2048 nt
    v_perm_b32 v61, v172, v168, s39
    v_perm_b32 v63, v172, v168, s40
    v_perm_b32 v65, v173, v169, s39
    v_perm_b32 v67, v173, v169, s40
    v_perm_b32 v69, v174, v170, s39
    v_perm_b32 v71, v174, v170, s40
    v_perm_b32 v73, v175, v171, s39
    v_perm_b32 v75, v175, v171, s40
    s_waitcnt lgkmcnt(0)
    v_mfma_f32_16x16x16_bf16 v[76:79], v[24:25], v[60:61], v[76:79]
    v_mfma_f32_16x16x16_bf16 v[80:83], v[24:25], v[62:63], v[80:83]
    v_mfma_f32_16x16x16_bf16 v[84:87], v[24:25], v[64:65], v[84:87]
    v_mfma_f32_16x16x16_bf16 v[88:91], v[24:25], v[66:67], v[88:91]
    v_mfma_f32_16x16x16_bf16 v[92:95], v[24:25], v[68:69], v[92:95]
    v_mfma_f32_16x16x16_bf16 v[96:99], v[24:25], v[70:71], v[96:99]
    v_mfma_f32_16x16x16_bf16 v[100:103], v[24:25], v[72:73], v[100:103]
    v_mfma_f32_16x16x16_bf16 v[104:107], v[24:25], v[74:75], v[104:107]
    s_sub_u32 s37, s37, 1
    s_cbranch_scc1 L_vdone
    s_memrealtime s[70:71]
    s_mov_b32 s74, s59
    v_add_u32 v8, 4, v8
    s_waitcnt lgkmcnt(0)
    s_or_b32 s59, s70, 1
    v_mov_b32 v1, s59
    s_mov_b64 exec, 1
    ds_write_b32 v8, v1
    s_mov_b64 exec, -1
    v_add_u32 v7, 0x100, v7
    s_branch L_vloop
L_vdone:
    v_lshl_add_u32 v1, v0, 5, s36
    v_lshl_add_u32 v2, v0, 3, s36
    v_lshlrev_b32 v3, 4, v0
    v_lshrrev_b32 v4, 5, v0
    v_lshlrev_b32 v4, 3, v4
    v_mov_b32 v176, 82560
    s_mov_b64 exec, 3
    ds_write_b64 v2, v[10:11] offset:1024
    s_mov_b64 exec, 0xffff
    ds_write2_b32 v1, v76, v80 offset0:0 offset1:1
    ds_write2_b32 v1, v77, v81 offset0:128 offset1:129
    ds_write2_b32 v1, v84, v88 offset0:2 offset1:3
    ds_write2_b32 v1, v85, v89 offset0:130 offset1:131
    ds_write2_b32 v1, v92, v96 offset0:4 offset1:5
    ds_write2_b32 v1, v93, v97 offset0:132 offset1:133
    ds_write2_b32 v1, v100, v104 offset0:6 offset1:7
    ds_write2_b32 v1, v101, v105 offset0:134 offset1:135
    s_mov_b64 exec, -1
    s_waitcnt lgkmcnt(0)
    s_barrier
    s_cmp_lg_u32 s32, 0
    s_cbranch_scc1 L_end
    ds_read_b32 v26, v176
    ds_read_b64 v[28:29], v4 offset:1024
    ds_read_b64 v[30:31], v4 offset:17408
    ds_read_b64 v[32:33], v4 offset:33792
    ds_read_b64 v[34:35], v4 offset:50176
    ds_read_b128 v[44:47], v3 offset:0
    ds_read_b128 v[48:51], v3 offset:16384
    ds_read_b128 v[52:55], v3 offset:32768
    ds_read_b128 v[56:59], v3 offset:49152
    s_lshl_b32 s41, s3, 11
    s_add_u32 s22, s20, s41
    s_addc_u32 s23, s21, 0
    v_lshlrev_b32 v4, 1, v4
    s_mov_b32 s76, 0x07060503
    s_mov_b32 s77, 0x07060502
    s_mov_b32 s78, 0x07060501
    s_waitcnt lgkmcnt(4)
    v_readfirstlane_b32 s42, v26
    v_max3_f32 v24, v28, v30, v32
    v_max_f32 v24, v24, v34
    v_sub_f32 v28, v28, v24
    v_sub_f32 v30, v30, v24
    v_sub_f32 v32, v32, v24
    v_sub_f32 v34, v34, v24
    v_exp_f32 v28, v28
    v_exp_f32 v30, v30
    v_exp_f32 v32, v32
    v_exp_f32 v34, v34
    s_cmp_eq_u32 s42, 0
    s_cbranch_scc1 L_tagwait
L_havetag:
    v_mul_f32 v25, v28, v29
    s_waitcnt lgkmcnt(0)
    v_mul_f32 v20, v28, v44
    v_mul_f32 v21, v28, v45
    v_mul_f32 v22, v28, v46
    v_mul_f32 v23, v28, v47
    v_fma_f32 v25, v30, v31, v25
    v_fma_f32 v20, v30, v48, v20
    v_fma_f32 v21, v30, v49, v21
    v_fma_f32 v22, v30, v50, v22
    v_fma_f32 v23, v30, v51, v23
    v_fma_f32 v25, v32, v33, v25
    v_fma_f32 v20, v32, v52, v20
    v_fma_f32 v21, v32, v53, v21
    v_fma_f32 v22, v32, v54, v22
    v_fma_f32 v23, v32, v55, v23
    v_fma_f32 v25, v34, v35, v25
    v_fma_f32 v20, v34, v56, v20
    v_fma_f32 v21, v34, v57, v21
    v_fma_f32 v22, v34, v58, v22
    v_fma_f32 v23, v34, v59, v23
    v_perm_b32 v20, v20, v23, s76
    v_perm_b32 v21, v21, v23, s77
    v_perm_b32 v22, v22, v23, s78
    v_mov_b32 v23, v26
    global_store_dwordx4 v3, v[20:23], s[22:23] sc1
    s_mov_b32 exec_lo, 1
    s_mov_b32 exec_hi, 1
    global_store_dwordx3 v4, v[24:26], s[22:23] offset:1024 sc1
L_end:
    s_endpgm
L_tagwait:
    s_mov_b32 s37, 1048576
L_tagwait1:
    s_sleep 1
    ds_read_b32 v26, v176
    s_waitcnt lgkmcnt(0)
    v_readfirstlane_b32 s42, v26
    s_sub_u32 s37, s37, 1
    s_cmp_eq_u32 s37, 0
    s_cbranch_scc1 L_havetag
    s_cmp_eq_u32 s42, 0
    s_cbranch_scc1 L_tagwait1
    s_branch L_havetag
L_helper:
    s_load_dwordx2 s[20:21], s[0:1], 64
    s_barrier
    s_lshr_b32 s33, s3, 2
    s_lshl2_add_u32 s3, s3, s34
    s_and_b32 s34, s3, 15
    v_lshlrev_b32 v3, 4, v0
    s_lshl_b32 s41, s33, 15
    s_mov_b32 s26, 0x8000
    s_mov_b32 s27, 0x20000
    s_sub_u32 s56, s34, s33
    s_and_b32 s56, s56, 15
    v_lshlrev_b32 v4, 11, v2
    v_and_b32 v5, 16, v0
    v_add_u32 v5, v5, v4
    s_waitcnt lgkmcnt(0)
    s_add_u32 s24, s20, s41
    s_addc_u32 s25, s21, 0
    s_lshl_b32 s41, s33, 2
    v_mov_b32 v6, s41
    s_and_b32 s41, s2, 3
    s_lshl_b32 s41, s41, 7
    s_add_u32 s41, s41, 82688
    v_mov_b32 v85, s41
    v_mov_b32 v91, 82432
    v_mov_b32 v94, 82560
    v_lshlrev_b32 v86, 8, v0
    s_sub_u32 s55, s2, 8
    s_lshl_b32 s41, s55, 8
    v_mov_b32 v87, s41
    v_mov_b32 v90, 0
    v_mov_b32 v7, 0
    s_mov_b32 s50, 1
    s_mov_b32 s51, 0
    s_mov_b32 s53, 0
    s_mov_b32 s54, 16384
    s_add_u32 s46, s20, 1048576
    s_addc_u32 s47, s21, 0
    s_cmp_lg_u32 s56, 0
    s_cbranch_scc1 L_cw
    buffer_load_dword v16, v5, s[24:27], 0 offen offset:1032 sc1
    s_movk_i32 s41, 0
    buffer_load_dword v17, v3, s[24:27], s41 offen offset:12 sc1
    buffer_load_dword v18, v3, s[24:27], s41 offen offset:2060 sc1
    s_movk_i32 s41, 4096
    buffer_load_dword v19, v3, s[24:27], s41 offen offset:12 sc1
    buffer_load_dword v20, v3, s[24:27], s41 offen offset:2060 sc1
    s_movk_i32 s41, 8192
    buffer_load_dword v21, v3, s[24:27], s41 offen offset:12 sc1
    buffer_load_dword v22, v3, s[24:27], s41 offen offset:2060 sc1
    s_movk_i32 s41, 12288
    buffer_load_dword v23, v3, s[24:27], s41 offen offset:12 sc1
    buffer_load_dword v24, v3, s[24:27], s41 offen offset:2060 sc1
    s_movk_i32 s41, 16384
    buffer_load_dword v25, v3, s[24:27], s41 offen offset:12 sc1
    buffer_load_dword v26, v3, s[24:27], s41 offen offset:2060 sc1
    s_movk_i32 s41, 20480
    buffer_load_dword v27, v3, s[24:27], s41 offen offset:12 sc1
    buffer_load_dword v28, v3, s[24:27], s41 offen offset:2060 sc1
    s_movk_i32 s41, 24576
    buffer_load_dword v29, v3, s[24:27], s41 offen offset:12 sc1
    buffer_load_dword v30, v3, s[24:27], s41 offen offset:2060 sc1
    s_movk_i32 s41, 28672
    buffer_load_dword v31, v3, s[24:27], s41 offen offset:12 sc1
    buffer_load_dword v32, v3, s[24:27], s41 offen offset:2060 sc1
    s_mov_b32 s41, 0
    s_waitcnt vmcnt(0)
L_pick:
    s_add_u32 s41, s41, 1
    s_mov_b64 s[44:45], 0
    v_cmp_eq_u32 vcc, s41, v16
    s_or_b64 s[44:45], s[44:45], vcc
    v_cmp_eq_u32 vcc, s41, v17
    s_or_b64 s[44:45], s[44:45], vcc
    v_cmp_eq_u32 vcc, s41, v18
    s_or_b64 s[44:45], s[44:45], vcc
    v_cmp_eq_u32 vcc, s41, v19
    s_or_b64 s[44:45], s[44:45], vcc
    v_cmp_eq_u32 vcc, s41, v20
    s_or_b64 s[44:45], s[44:45], vcc
    v_cmp_eq_u32 vcc, s41, v21
    s_or_b64 s[44:45], s[44:45], vcc
    v_cmp_eq_u32 vcc, s41, v22
    s_or_b64 s[44:45], s[44:45], vcc
    v_cmp_eq_u32 vcc, s41, v23
    s_or_b64 s[44:45], s[44:45], vcc
    v_cmp_eq_u32 vcc, s41, v24
    s_or_b64 s[44:45], s[44:45], vcc
    v_cmp_eq_u32 vcc, s41, v25
    s_or_b64 s[44:45], s[44:45], vcc
    v_cmp_eq_u32 vcc, s41, v26
    s_or_b64 s[44:45], s[44:45], vcc
    v_cmp_eq_u32 vcc, s41, v27
    s_or_b64 s[44:45], s[44:45], vcc
    v_cmp_eq_u32 vcc, s41, v28
    s_or_b64 s[44:45], s[44:45], vcc
    v_cmp_eq_u32 vcc, s41, v29
    s_or_b64 s[44:45], s[44:45], vcc
    v_cmp_eq_u32 vcc, s41, v30
    s_or_b64 s[44:45], s[44:45], vcc
    v_cmp_eq_u32 vcc, s41, v31
    s_or_b64 s[44:45], s[44:45], vcc
    v_cmp_eq_u32 vcc, s41, v32
    s_or_b64 s[44:45], s[44:45], vcc
    s_cbranch_scc1 L_pick
    v_mov_b32 v12, s41
    s_mov_b64 exec, 1
    global_store_dword v6, v12, s[18:19] sc1
    s_mov_b64 exec, -1
L_cw:
    ds_read_b32 v89, v85
    s_waitcnt lgkmcnt(0)
    v_readfirstlane_b32 s41, v89
    s_cmp_lg_u32 s41, 0
    s_cbranch_scc1 L_cgo
    s_sleep 1
    s_sub_u32 s54, s54, 1
    s_cmp_lg_u32 s54, 0
    s_cbranch_scc1 L_cw
    s_branch L_cend
L_cgo:
    s_mov_b32 s52, s51
    s_mov_b32 s51, s41
    v_add_u32 v85, 4, v85
    v_add_u32 v91, 4, v91
    s_cmp_eq_u32 s50, 1
    s_cbranch_scc1 L_noload
    s_mov_b64 exec, 255
    global_load_dword v90, v86, s[46:47]
L_noload:
    s_add_u32 s46, s46, 4352
    s_addc_u32 s47, s47, 0
    s_mov_b64 exec, 1
    s_cmp_ge_u32 s55, 8
    s_cbranch_scc1 L_nomark
    global_store_dword v87, v89, s[46:47] sc1
L_nomark:
    s_cmp_lg_u32 s50, 2
    s_cbranch_scc1 L_noget
    global_load_dword v7, v6, s[18:19] sc1
L_noget:
    s_mov_b64 exec, -1
    s_waitcnt vmcnt(0)
    v_subrev_u32 v93, s52, v90
    v_add_u32 v89, 512, v93
    v_cmp_gt_u32 vcc, 0x400, v89
    v_readfirstlane_b32 s53, v7
    s_nop 0
    v_cndmask_b32 v92, 0, v93, vcc
    s_nop 1
    v_add_u32_dpp v92, v92, v92 row_ror:1 row_mask:0xf bank_mask:0xf
    s_nop 1
    v_add_u32_dpp v92, v92, v92 row_ror:2 row_mask:0xf bank_mask:0xf
    s_nop 1
    v_add_u32_dpp v92, v92, v92 row_ror:4 row_mask:0xf bank_mask:0xf
    s_nop 1
    v_add_u32_dpp v92, v92, v92 row_ror:8 row_mask:0xf bank_mask:0xf
    v_ashrrev_i32 v92, 3, v92
    v_add_u32 v92, s52, v92
    s_mov_b64 exec, 1
    ds_write_b32 v91, v92
    ds_write_b32 v94, v7
    s_mov_b64 exec, -1
    s_add_u32 s50, s50, 1
    s_cmp_le_u32 s50, 14
    s_cbranch_scc1 L_cw
L_cend:
    s_mov_b32 s37, 1048576
L_tagspin:
    s_cmp_lg_u32 s53, 0
    s_cbranch_scc1 L_tagok
    global_load_dword v7, v6, s[18:19] sc1
    s_waitcnt vmcnt(0)
    v_readfirstlane_b32 s53, v7
    ds_write_b32 v94, v7
    s_waitcnt lgkmcnt(0)
    s_sub_u32 s37, s37, 1
    s_cmp_lg_u32 s37, 0
    s_cbranch_scc1 L_tagspin
L_tagok:
    s_and_b32 s41, s56, 3
    s_cbranch_scc1 L_end
    s_lshl_b32 s41, s56, 6
    v_lshl_add_u32 v3, v2, 4, s41
    v_lshl_add_u32 v3, v1, 11, v3
    v_add_u32 v5, v1, v2
    v_and_b32 v5, 15, v5
    v_lshlrev_b32 v5, 11, v5
    s_lshr_b32 s41, s56, 3
    s_lshl_b32 s41, s41, 4
    v_add_u32 v5, s41, v5
    s_lshl_b32 s41, s33, 9
    s_lshl_b32 s42, s56, 5
    s_add_u32 s41, s41, s42
    v_lshl_add_u32 v6, v2, 3, s41
    v_lshl_add_u32 v6, v1, 1, v6
    s_mov_b32 s37, 1048576
    s_movk_i32 s76, 0x2000
    s_movk_i32 s77, 0x4000
    s_movk_i32 s78, 0x6000
    s_mov_b32 s79, 0x0004000c
    s_mov_b32 s80, 0x04020100
    buffer_load_dwordx3 v[16:18], v5, s[24:27], 0 offen offset:1024 sc1
    buffer_load_dwordx4 v[20:23], v3, s[24:27], 0 offen sc1
    buffer_load_dwordx4 v[24:27], v3, s[24:27], s76 offen sc1
    buffer_load_dwordx4 v[28:31], v3, s[24:27], s77 offen sc1
    buffer_load_dwordx4 v[32:35], v3, s[24:27], s78 offen sc1
    buffer_load_dwordx3 v[40:42], v5, s[24:27], 0 offen offset:1024 sc1
    buffer_load_dwordx4 v[44:47], v3, s[24:27], 0 offen sc1
    buffer_load_dwordx4 v[48:51], v3, s[24:27], s76 offen sc1
    buffer_load_dwordx4 v[52:55], v3, s[24:27], s77 offen sc1
    buffer_load_dwordx4 v[56:59], v3, s[24:27], s78 offen sc1
L_poll:
    s_waitcnt vmcnt(9)
    v_cmp_ne_u32 s[44:45], s53, v18
    v_mov_b32 v8, v16
    s_nop 1
    v_max_f32_dpp v8, v8, v8 row_ror:1 row_mask:0xf bank_mask:0xf
    s_nop 1
    v_max_f32_dpp v8, v8, v8 row_ror:2 row_mask:0xf bank_mask:0xf
    s_nop 1
    v_max_f32_dpp v8, v8, v8 row_ror:4 row_mask:0xf bank_mask:0xf
    s_nop 1
    v_max_f32_dpp v8, v8, v8 row_ror:8 row_mask:0xf bank_mask:0xf
    v_sub_f32 v8, v16, v8
    v_exp_f32 v8, v8
    s_nop 0
    v_mul_f32 v9, v8, v17
    s_nop 1
    v_add_f32_dpp v9, v9, v9 row_ror:1 row_mask:0xf bank_mask:0xf
    s_nop 1
    v_add_f32_dpp v9, v9, v9 row_ror:2 row_mask:0xf bank_mask:0xf
    s_nop 1
    v_add_f32_dpp v9, v9, v9 row_ror:4 row_mask:0xf bank_mask:0xf
    s_nop 1
    v_add_f32_dpp v9, v9, v9 row_ror:8 row_mask:0xf bank_mask:0xf
    v_rcp_f32 v9, v9
    v_mov_b32 v12, 0
    v_mov_b32 v13, 0
    v_mov_b32 v14, 0
    v_mov_b32 v15, 0
    v_mul_f32 v8, v8, v9
    s_waitcnt vmcnt(5)
    v_cmp_ne_u32 vcc, s53, v23
    v_perm_b32 v10, v21, v22, s79
    v_perm_b32 v10, v20, v10, s80
    s_or_b64 s[44:45], s[44:45], vcc
    v_fmac_f32_dpp v12, v8, v20 row_newbcast:0 row_mask:0xf bank_mask:0xf
    v_fmac_f32_dpp v13, v8, v21 row_newbcast:0 row_mask:0xf bank_mask:0xf
    v_fmac_f32_dpp v14, v8, v22 row_newbcast:0 row_mask:0xf bank_mask:0xf
    v_fmac_f32_dpp v15, v8, v10 row_newbcast:0 row_mask:0xf bank_mask:0xf
    v_cmp_ne_u32 vcc, s53, v27
    v_perm_b32 v10, v25, v26, s79
    v_perm_b32 v10, v24, v10, s80
    s_or_b64 s[44:45], s[44:45], vcc
    v_fmac_f32_dpp v12, v8, v24 row_newbcast:4 row_mask:0xf bank_mask:0xf
    v_fmac_f32_dpp v13, v8, v25 row_newbcast:4 row_mask:0xf bank_mask:0xf
    v_fmac_f32_dpp v14, v8, v26 row_newbcast:4 row_mask:0xf bank_mask:0xf
    v_fmac_f32_dpp v15, v8, v10 row_newbcast:4 row_mask:0xf bank_mask:0xf
    v_cmp_ne_u32 vcc, s53, v31
    v_perm_b32 v10, v29, v30, s79
    v_perm_b32 v10, v28, v10, s80
    s_or_b64 s[44:45], s[44:45], vcc
    v_fmac_f32_dpp v12, v8, v28 row_newbcast:8 row_mask:0xf bank_mask:0xf
    v_fmac_f32_dpp v13, v8, v29 row_newbcast:8 row_mask:0xf bank_mask:0xf
    v_fmac_f32_dpp v14, v8, v30 row_newbcast:8 row_mask:0xf bank_mask:0xf
    v_fmac_f32_dpp v15, v8, v10 row_newbcast:8 row_mask:0xf bank_mask:0xf
    v_cmp_ne_u32 vcc, s53, v35
    v_perm_b32 v10, v33, v34, s79
    v_perm_b32 v10, v32, v10, s80
    s_or_b64 s[44:45], s[44:45], vcc
    v_fmac_f32_dpp v12, v8, v32 row_newbcast:12 row_mask:0xf bank_mask:0xf
    v_fmac_f32_dpp v13, v8, v33 row_newbcast:12 row_mask:0xf bank_mask:0xf
    v_fmac_f32_dpp v14, v8, v34 row_newbcast:12 row_mask:0xf bank_mask:0xf
    v_fmac_f32_dpp v15, v8, v10 row_newbcast:12 row_mask:0xf bank_mask:0xf
    s_nop 1
    v_permlane16_swap_b32 v12, v13
    v_permlane16_swap_b32 v14, v15
    v_add_f32 v12, v12, v13
    v_add_f32 v14, v14, v15
    s_cmp_eq_u64 s[44:45], 0
    s_nop 0
    v_permlane32_swap_b32 v12, v14
    v_add_f32 v12, v12, v14
    v_cvt_pk_bf16_f32 v12, v12, v12
    s_cbranch_scc1 L_polldone
    s_cmp_eq_u32 s37, 1048576
    s_cbranch_scc1 L_first
    buffer_load_dwordx3 v[16:18], v5, s[24:27], 0 offen offset:1024 sc1
    buffer_load_dwordx4 v[20:23], v3, s[24:27], 0 offen sc1
    buffer_load_dwordx4 v[24:27], v3, s[24:27], s76 offen sc1
    buffer_load_dwordx4 v[28:31], v3, s[24:27], s77 offen sc1
    buffer_load_dwordx4 v[32:35], v3, s[24:27], s78 offen sc1
L_second:
    s_waitcnt vmcnt(9)
    v_cmp_ne_u32 s[44:45], s53, v42
    v_mov_b32 v8, v40
    s_nop 1
    v_max_f32_dpp v8, v8, v8 row_ror:1 row_mask:0xf bank_mask:0xf
    s_nop 1
    v_max_f32_dpp v8, v8, v8 row_ror:2 row_mask:0xf bank_mask:0xf
    s_nop 1
    v_max_f32_dpp v8, v8, v8 row_ror:4 row_mask:0xf bank_mask:0xf
    s_nop 1
    v_max_f32_dpp v8, v8, v8 row_ror:8 row_mask:0xf bank_mask:0xf
    v_sub_f32 v8, v40, v8
    v_exp_f32 v8, v8
    s_nop 0
    v_mul_f32 v9, v8, v41
    s_nop 1
    v_add_f32_dpp v9, v9, v9 row_ror:1 row_mask:0xf bank_mask:0xf
    s_nop 1
    v_add_f32_dpp v9, v9, v9 row_ror:2 row_mask:0xf bank_mask:0xf
    s_nop 1
    v_add_f32_dpp v9, v9, v9 row_ror:4 row_mask:0xf bank_mask:0xf
    s_nop 1
    v_add_f32_dpp v9, v9, v9 row_ror:8 row_mask:0xf bank_mask:0xf
    v_rcp_f32 v9, v9
    v_mov_b32 v12, 0
    v_mov_b32 v13, 0
    v_mov_b32 v14, 0
    v_mov_b32 v15, 0
    v_mul_f32 v8, v8, v9
    s_waitcnt vmcnt(5)
    v_cmp_ne_u32 vcc, s53, v47
    v_perm_b32 v10, v45, v46, s79
    v_perm_b32 v10, v44, v10, s80
    s_or_b64 s[44:45], s[44:45], vcc
    v_fmac_f32_dpp v12, v8, v44 row_newbcast:0 row_mask:0xf bank_mask:0xf
    v_fmac_f32_dpp v13, v8, v45 row_newbcast:0 row_mask:0xf bank_mask:0xf
    v_fmac_f32_dpp v14, v8, v46 row_newbcast:0 row_mask:0xf bank_mask:0xf
    v_fmac_f32_dpp v15, v8, v10 row_newbcast:0 row_mask:0xf bank_mask:0xf
    v_cmp_ne_u32 vcc, s53, v51
    v_perm_b32 v10, v49, v50, s79
    v_perm_b32 v10, v48, v10, s80
    s_or_b64 s[44:45], s[44:45], vcc
    v_fmac_f32_dpp v12, v8, v48 row_newbcast:4 row_mask:0xf bank_mask:0xf
    v_fmac_f32_dpp v13, v8, v49 row_newbcast:4 row_mask:0xf bank_mask:0xf
    v_fmac_f32_dpp v14, v8, v50 row_newbcast:4 row_mask:0xf bank_mask:0xf
    v_fmac_f32_dpp v15, v8, v10 row_newbcast:4 row_mask:0xf bank_mask:0xf
    v_cmp_ne_u32 vcc, s53, v55
    v_perm_b32 v10, v53, v54, s79
    v_perm_b32 v10, v52, v10, s80
    s_or_b64 s[44:45], s[44:45], vcc
    v_fmac_f32_dpp v12, v8, v52 row_newbcast:8 row_mask:0xf bank_mask:0xf
    v_fmac_f32_dpp v13, v8, v53 row_newbcast:8 row_mask:0xf bank_mask:0xf
    v_fmac_f32_dpp v14, v8, v54 row_newbcast:8 row_mask:0xf bank_mask:0xf
    v_fmac_f32_dpp v15, v8, v10 row_newbcast:8 row_mask:0xf bank_mask:0xf
    v_cmp_ne_u32 vcc, s53, v59
    v_perm_b32 v10, v57, v58, s79
    v_perm_b32 v10, v56, v10, s80
    s_or_b64 s[44:45], s[44:45], vcc
    v_fmac_f32_dpp v12, v8, v56 row_newbcast:12 row_mask:0xf bank_mask:0xf
    v_fmac_f32_dpp v13, v8, v57 row_newbcast:12 row_mask:0xf bank_mask:0xf
    v_fmac_f32_dpp v14, v8, v58 row_newbcast:12 row_mask:0xf bank_mask:0xf
    v_fmac_f32_dpp v15, v8, v10 row_newbcast:12 row_mask:0xf bank_mask:0xf
    s_nop 1
    v_permlane16_swap_b32 v12, v13
    v_permlane16_swap_b32 v14, v15
    v_add_f32 v12, v12, v13
    v_add_f32 v14, v14, v15
    s_cmp_eq_u64 s[44:45], 0
    s_nop 0
    v_permlane32_swap_b32 v12, v14
    v_add_f32 v12, v12, v14
    v_cvt_pk_bf16_f32 v12, v12, v12
    s_cbranch_scc1 L_polldone
    s_cmp_lg_u32 s37, 1048576
    s_cbranch_scc1 L_again
    s_barrier
    buffer_load_dwordx3 v[16:18], v5, s[24:27], 0 offen offset:1024 sc1
    buffer_load_dwordx4 v[20:23], v3, s[24:27], 0 offen sc1
    buffer_load_dwordx4 v[24:27], v3, s[24:27], s76 offen sc1
    buffer_load_dwordx4 v[28:31], v3, s[24:27], s77 offen sc1
    buffer_load_dwordx4 v[32:35], v3, s[24:27], s78 offen sc1
L_again:
    buffer_load_dwordx3 v[40:42], v5, s[24:27], 0 offen offset:1024 sc1
    buffer_load_dwordx4 v[44:47], v3, s[24:27], 0 offen sc1
    buffer_load_dwordx4 v[48:51], v3, s[24:27], s76 offen sc1
    buffer_load_dwordx4 v[52:55], v3, s[24:27], s77 offen sc1
    buffer_load_dwordx4 v[56:59], v3, s[24:27], s78 offen sc1
    s_sub_u32 s37, s37, 1
    s_cmp_lg_u32 s37, 0
    s_cbranch_scc1 L_poll
L_polldone:
    global_store_short v6, v12, s[16:17]
    s_endpgm
L_first:
    s_waitcnt vmcnt(0)
    s_branch L_second
.section .rodata,"a"
.p2align 6
.amdhsa_kernel standalone__tree_speculative_verify_tree_attention_over_candidate_token_tree__decode_kernel
  .amdhsa_next_free_vgpr 177
  .amdhsa_next_free_sgpr 82
  .amdhsa_accum_offset 180
  .amdhsa_group_segment_fixed_size 0
  .amdhsa_kernarg_size 72
  .amdhsa_user_sgpr_count 2
  .amdhsa_user_sgpr_kernarg_segment_ptr 1
  .amdhsa_system_sgpr_workgroup_id_x 1
.end_amdhsa_kernel
```
